```python
import torch

def _softmax(x, axis=-1):
    return torch.softmax(x, dim=axis)
def _gelu(x):
    return torch.nn.functional.gelu(x, approximate="tanh")
def _silu(x):
    return torch.nn.functional.silu(x)
def _sigmoid(x):
    return torch.sigmoid(x)
def _layernorm(x, axis=-1, eps=1e-5):
    m = x.mean(dim=axis, keepdim=True)
    v = x.var(dim=axis, keepdim=True, unbiased=False)
    return (x - m) / torch.sqrt(v + eps)
def _scatter_add(tgt, idx, src, axis=0):
    return tgt.clone().index_add_(axis, idx, src)
def _segment_sum(src, seg, n):
    out = torch.zeros((n,) + src.shape[1:], dtype=src.dtype)
    return out.index_add_(0, seg, src)
def _pad(x, pw):
    flat = tuple(v for pair in reversed(pw) for v in pair)
    return torch.nn.functional.pad(x, flat)

kernel_name = 'standalone__weight_only_int_gptq__prompt'

def setup_inputs():

    _w = (lambda a: (lambda t: t.to(torch.bfloat16) if t.is_floating_point() else t)(torch.as_tensor(a)))
    B, S, D, F = 1, 2048, 576, 4608
    bits = max(2, min(4, 3))
    pf = 32 // bits
    G = -1 if -1 > 0 else D
    G = max(pf, (G // pf) * pf)
    D = max(G, (D // G) * G)
    ng = D // G
    qmax = 1 << bits
    qw = torch.randint(0, qmax, (D, F)).to(torch.int64)
    packed = torch.zeros((D // pf, F), dtype=torch.int64)
    for i in range(pf):
        packed |= (qw[i::pf] << (i * bits))
    packed = packed.to(torch.int32)
    return {
        "x": _w((lambda *s: torch.randn(*s, dtype=torch.bfloat16) * 0.05)(B, S, D)),
        "qw_packed": _w(packed),
        "scales": _w(torch.abs((lambda *s: torch.randn(*s, dtype=torch.bfloat16) * 0.05)(ng, F)).to(float) * 0.1 + 0.01),
        "zeros": _w(torch.randint(0, qmax, (ng, F)).to(float)),
        "bits": _w((lambda _x: torch.as_tensor(_x, dtype=torch.int32))(bits)),
    }

def reference(x, qw_packed, scales, zeros, bits):
    b = int(bits)
    pf = 32 // b
    mask = (1 << b) - 1
    P, F = qw_packed.shape
    D = P * pf
    ng = scales.shape[0]
    G = D // ng
    shifts = (lambda x, dt: x.to(dt))(torch.arange(pf) * b, qw_packed.dtype)
    qw = ((qw_packed[:, None, :] >> shifts[None, :, None]) & mask).reshape(D, F)
    s = (lambda x, n, axis: torch.repeat_interleave(x, n, dim=axis))(scales, G, axis=0)
    z = (lambda x, n, axis: torch.repeat_interleave(x, n, dim=axis))(zeros, G, axis=0)
    w = ((lambda x, dt: x.to(dt))(qw, x.dtype) - z) * s
    return torch.einsum("bsd,df->bsf", x, w)
```

```asm
; @launch grid=(256,1,1) block=(512,1,1) lds=163840
.amdgcn_target "amdgcn-amd-amdhsa--gfx950"
.text
.globl standalone__weight_only_int_gptq__prompt_kernel
.p2align 8
.type standalone__weight_only_int_gptq__prompt_kernel,@function
standalone__weight_only_int_gptq__prompt_kernel:
    s_cmp_ge_u32 s2, 256
    s_cbranch_scc1 L_exit
    s_load_dwordx4 s[36:39], s[0:1], 0
    s_load_dwordx4 s[40:43], s[0:1], 16
    s_load_dwordx2 s[44:45], s[0:1], 40
    v_lshrrev_b32 v1, 6, v0
    v_and_b32 v2, 31, v0
    v_readfirstlane_b32 s24, v1
    v_and_b32 v1, 63, v0
    v_lshrrev_b32 v3, 5, v1
    s_lshr_b32 s25, s2, 4
    s_and_b32 s26, s2, 15
    s_mov_b32 s28, 0x05010400
    s_mov_b32 s29, 0x07030602
    s_lshl_b32 s30, s25, 7
    s_lshl_b32 s31, s24, 6
    v_add_u32 v34, s31, v1
    v_mul_u32_u24 v35, 6554, v34
    v_lshrrev_b32 v35, 16, v35
    v_mul_u32_u24 v36, 10, v35
    v_sub_u32 v36, v34, v36
    v_bfe_u32 v37, v35, 3, 1
    v_sub_u32 v36, v36, v37
    v_add_u32 v37, 10, v36
    v_min_u32 v36, v36, v37
    v_add_u32 v35, s30, v35
    v_mul_u32_u24 v35, 1140, v35
    v_lshl_add_u32 v4, v36, 4, v35
    v_add_u32 v34, s31, v1
    v_add_u32 v34, 512, v34
    v_mul_u32_u24 v35, 6554, v34
    v_lshrrev_b32 v35, 16, v35
    v_mul_u32_u24 v36, 10, v35
    v_sub_u32 v36, v34, v36
    v_bfe_u32 v37, v35, 3, 1
    v_sub_u32 v36, v36, v37
    v_add_u32 v37, 10, v36
    v_min_u32 v36, v36, v37
    v_add_u32 v35, s30, v35
    v_mul_u32_u24 v35, 1140, v35
    v_lshl_add_u32 v5, v36, 4, v35
    v_add_u32 v34, s31, v1
    v_add_u32 v34, 1024, v34
    v_mul_u32_u24 v35, 6554, v34
    v_lshrrev_b32 v35, 16, v35
    v_mul_u32_u24 v36, 10, v35
    v_sub_u32 v36, v34, v36
    v_bfe_u32 v37, v35, 3, 1
    v_sub_u32 v36, v36, v37
    v_add_u32 v37, 10, v36
    v_min_u32 v36, v36, v37
    v_add_u32 v35, s30, v35
    v_mul_u32_u24 v35, 1140, v35
    v_lshl_add_u32 v6, v36, 4, v35
    s_lshl_b32 s27, s24, 10
    v_bfe_u32 v34, v2, 3, 1
    v_mul_u32_u24 v35, 160, v2
    v_mul_u32_u24 v37, 5, v3
    v_add_u32 v37, v37, v34
    s_mul_i32 s31, s24, 5120
    v_add_u32 v36, 0, v37
    v_subrev_u32 v38, 10, v36
    v_min_u32 v36, v36, v38
    v_lshl_add_u32 v16, v36, 4, v35
    v_add_u32 v21, s31, v16
    v_add_u32 v36, 1, v37
    v_subrev_u32 v38, 10, v36
    v_min_u32 v36, v36, v38
    v_lshl_add_u32 v17, v36, 4, v35
    v_add_u32 v22, s31, v17
    v_add_u32 v36, 2, v37
    v_subrev_u32 v38, 10, v36
    v_min_u32 v36, v36, v38
    v_lshl_add_u32 v18, v36, 4, v35
    v_add_u32 v23, s31, v18
    v_add_u32 v36, 3, v37
    v_subrev_u32 v38, 10, v36
    v_min_u32 v36, v36, v38
    v_lshl_add_u32 v19, v36, 4, v35
    v_add_u32 v24, s31, v19
    v_add_u32 v36, 4, v37
    v_subrev_u32 v38, 10, v36
    v_min_u32 v36, v36, v38
    v_lshl_add_u32 v20, v36, 4, v35
    v_add_u32 v25, s31, v20
    v_add_u32 v36, v3, v34
    v_lshl_add_u32 v36, v36, 4, v35
    v_add_u32 v14, 143360, v36
    v_add_u32 v15, s31, v14
    s_mul_i32 s30, s26, 288
    s_lshl_b32 s31, s24, 5
    s_add_u32 s30, s30, s31
    v_add_u32 v34, s30, v2
    v_lshlrev_b32 v9, 2, v34
    v_mul_u32_u24 v35, 73728, v3
    v_add_u32 v7, v9, v35
    s_lshl_b32 s31, s24, 7
    s_sub_u32 s31, 1024, s31
    v_add_u32 v10, s31, v9
    v_add_u32 v8, s31, v7
    v_mul_u32_u24 v12, 24, v3
    v_subrev_u32 v13, 1, v3
    s_lshl_b32 s31, s25, 7
    v_add_u32 v34, s31, v2
    v_mul_u32_u24 v34, 9, v34
    v_lshlrev_b32 v34, 10, v34
    v_lshlrev_b32 v35, 3, v3
    v_add_u32 v35, s30, v35
    v_lshl_add_u32 v11, v35, 1, v34
    s_waitcnt lgkmcnt(0)
    s_mov_b32 s4, s36
    s_and_b32 s5, s37, 0xffff
    s_mov_b32 s6, 2334720
    s_mov_b32 s7, 0x00020000
    s_mov_b32 s8, s38
    s_and_b32 s9, s39, 0xffff
    s_mov_b32 s10, 1050624
    s_mov_b32 s11, 0x00020000
    s_mov_b32 s12, s40
    s_and_b32 s13, s41, 0xffff
    s_mov_b32 s14, 9216
    s_mov_b32 s15, 0x00020000
    s_mov_b32 s16, s42
    s_and_b32 s17, s43, 0xffff
    s_mov_b32 s18, 9216
    s_mov_b32 s19, 0x00020000
    s_mov_b32 s20, s44
    s_and_b32 s21, s45, 0xffff
    s_mov_b32 s22, 18874368
    s_mov_b32 s23, 0x00020000
    s_cmp_ge_u32 s24, 4
    s_cbranch_scc1 L_bwave
    v_mov_b32 v120, 0
    v_mov_b32 v121, 0
    v_mov_b32 v122, 0
    v_mov_b32 v123, 0
    v_mov_b32 v124, 0
    v_mov_b32 v125, 0
    v_mov_b32 v126, 0
    v_mov_b32 v127, 0
    v_mov_b32 v128, 0
    v_mov_b32 v129, 0
    v_mov_b32 v130, 0
    v_mov_b32 v131, 0
    v_mov_b32 v132, 0
    v_mov_b32 v133, 0
    v_mov_b32 v134, 0
    v_mov_b32 v135, 0
    v_mov_b32 v136, 0
    v_mov_b32 v137, 0
    v_mov_b32 v138, 0
    v_mov_b32 v139, 0
    v_mov_b32 v140, 0
    v_mov_b32 v141, 0
    v_mov_b32 v142, 0
    v_mov_b32 v143, 0
    v_mov_b32 v144, 0
    v_mov_b32 v145, 0
    v_mov_b32 v146, 0
    v_mov_b32 v147, 0
    v_mov_b32 v148, 0
    v_mov_b32 v149, 0
    v_mov_b32 v150, 0
    v_mov_b32 v151, 0
    v_mov_b32 v152, 0
    v_mov_b32 v153, 0
    v_mov_b32 v154, 0
    v_mov_b32 v155, 0
    v_mov_b32 v156, 0
    v_mov_b32 v157, 0
    v_mov_b32 v158, 0
    v_mov_b32 v159, 0
    v_mov_b32 v160, 0
    v_mov_b32 v161, 0
    v_mov_b32 v162, 0
    v_mov_b32 v163, 0
    v_mov_b32 v164, 0
    v_mov_b32 v165, 0
    v_mov_b32 v166, 0
    v_mov_b32 v167, 0
    v_mov_b32 v168, 0
    v_mov_b32 v169, 0
    v_mov_b32 v170, 0
    v_mov_b32 v171, 0
    v_mov_b32 v172, 0
    v_mov_b32 v173, 0
    v_mov_b32 v174, 0
    v_mov_b32 v175, 0
    v_mov_b32 v176, 0
    v_mov_b32 v177, 0
    v_mov_b32 v178, 0
    v_mov_b32 v179, 0
    v_mov_b32 v180, 0
    v_mov_b32 v181, 0
    v_mov_b32 v182, 0
    v_mov_b32 v183, 0
    v_mov_b32 v184, 0
    v_mov_b32 v185, 0
    v_mov_b32 v186, 0
    v_mov_b32 v187, 0
    v_mov_b32 v188, 0
    v_mov_b32 v189, 0
    v_mov_b32 v190, 0
    v_mov_b32 v191, 0
    v_mov_b32 v192, 0
    v_mov_b32 v193, 0
    v_mov_b32 v194, 0
    v_mov_b32 v195, 0
    v_mov_b32 v196, 0
    v_mov_b32 v197, 0
    v_mov_b32 v198, 0
    v_mov_b32 v199, 0
    s_add_u32 s30, s27, 143360
    v_lshrrev_b32 v34, 1, v9
    buffer_load_ushort v40, v34, s[16:19], 0 offen
    buffer_load_ushort v41, v34, s[12:15], 0 offen
    v_lshrrev_b32 v34, 1, v10
    buffer_load_ushort v112, v34, s[16:19], 0 offen
    buffer_load_ushort v116, v34, s[12:15], 0 offen
    s_mov_b32 s47, 0
    s_mov_b32 s48, 0
    s_mov_b32 s49, s27
    s_add_u32 s32, s47, 0
    buffer_load_dword v46, v7, s[8:11], s32 offen
    s_add_u32 s32, s47, 18432
    buffer_load_dword v47, v7, s[8:11], s32 offen
    s_add_u32 s32, s47, 36864
    buffer_load_dword v48, v7, s[8:11], s32 offen
    s_add_u32 s32, s47, 55296
    buffer_load_dword v49, v7, s[8:11], s32 offen
    s_add_u32 s32, s47, 0
    buffer_load_dword v55, v8, s[8:11], s32 offen
    s_add_u32 s32, s47, 18432
    buffer_load_dword v56, v8, s[8:11], s32 offen
    s_add_u32 s32, s47, 36864
    buffer_load_dword v57, v8, s[8:11], s32 offen
    s_add_u32 s32, s47, 55296
    buffer_load_dword v58, v8, s[8:11], s32 offen
    s_add_u32 m0, s49, 0
    s_nop 0
    buffer_load_dwordx4 v4, s[4:7], s48 offen lds
    s_add_u32 m0, s49, 8192
    s_nop 0
    buffer_load_dwordx4 v5, s[4:7], s48 offen lds
    s_add_u32 m0, s49, 16384
    s_nop 0
    buffer_load_dwordx4 v6, s[4:7], s48 offen lds
    s_add_u32 s48, s48, 160
    s_min_u32 s48, s48, 1120
    s_add_u32 s49, s49, 20480
    s_min_u32 s49, s49, s30
    s_mov_b32 s32, 1032192
    buffer_load_dword v54, v9, s[8:11], s32 offen
    s_mov_b32 s32, 1032192
    buffer_load_dword v63, v10, s[8:11], s32 offen
    s_add_u32 m0, s49, 0
    s_nop 0
    buffer_load_dwordx4 v4, s[4:7], s48 offen lds
    s_add_u32 m0, s49, 8192
    s_nop 0
    buffer_load_dwordx4 v5, s[4:7], s48 offen lds
    s_add_u32 m0, s49, 16384
    s_nop 0
    buffer_load_dwordx4 v6, s[4:7], s48 offen lds
    s_add_u32 s48, s48, 160
    s_min_u32 s48, s48, 1120
    s_add_u32 s49, s49, 20480
    s_min_u32 s49, s49, s30
    s_waitcnt vmcnt(16)
    v_lshlrev_b32 v40, 16, v40
    v_lshlrev_b32 v41, 16, v41
    v_sub_f32 v34, 0, v40
    v_sub_f32 v35, 1.0, v40
    v_cvt_pk_bf16_f32 v36, v34, v35
    v_lshlrev_b32 v37, 16, v36
    v_and_b32 v38, 0xffff0000, v36
    v_mul_f32 v37, v37, v41
    v_mul_f32 v38, v38, v41
    v_cvt_pk_bf16_f32 v42, v37, v38
    v_sub_f32 v34, 2.0, v40
    v_sub_f32 v35, 0x40400000, v40
    v_cvt_pk_bf16_f32 v36, v34, v35
    v_lshlrev_b32 v37, 16, v36
    v_and_b32 v38, 0xffff0000, v36
    v_mul_f32 v37, v37, v41
    v_mul_f32 v38, v38, v41
    v_cvt_pk_bf16_f32 v43, v37, v38
    v_sub_f32 v34, 4.0, v40
    v_sub_f32 v35, 0x40a00000, v40
    v_cvt_pk_bf16_f32 v36, v34, v35
    v_lshlrev_b32 v37, 16, v36
    v_and_b32 v38, 0xffff0000, v36
    v_mul_f32 v37, v37, v41
    v_mul_f32 v38, v38, v41
    v_cvt_pk_bf16_f32 v44, v37, v38
    v_sub_f32 v34, 0x40c00000, v40
    v_sub_f32 v35, 0x40e00000, v40
    v_cvt_pk_bf16_f32 v36, v34, v35
    v_lshlrev_b32 v37, 16, v36
    v_and_b32 v38, 0xffff0000, v36
    v_mul_f32 v37, v37, v41
    v_mul_f32 v38, v38, v41
    v_cvt_pk_bf16_f32 v45, v37, v38
    s_mov_b32 s33, 0x06040200
    s_mov_b32 s31, 0x07050301
    v_perm_b32 v26, v43, v42, s33
    v_perm_b32 v27, v45, v44, s33
    v_perm_b32 v28, v43, v42, s31
    v_perm_b32 v29, v45, v44, s31
    v_lshlrev_b32 v112, 16, v112
    v_lshlrev_b32 v116, 16, v116
    v_sub_f32 v34, 0, v112
    v_sub_f32 v35, 1.0, v112
    v_cvt_pk_bf16_f32 v36, v34, v35
    v_lshlrev_b32 v37, 16, v36
    v_and_b32 v38, 0xffff0000, v36
    v_mul_f32 v37, v37, v116
    v_mul_f32 v38, v38, v116
    v_cvt_pk_bf16_f32 v42, v37, v38
    v_sub_f32 v34, 2.0, v112
    v_sub_f32 v35, 0x40400000, v112
    v_cvt_pk_bf16_f32 v36, v34, v35
    v_lshlrev_b32 v37, 16, v36
    v_and_b32 v38, 0xffff0000, v36
    v_mul_f32 v37, v37, v116
    v_mul_f32 v38, v38, v116
    v_cvt_pk_bf16_f32 v43, v37, v38
    v_sub_f32 v34, 4.0, v112
    v_sub_f32 v35, 0x40a00000, v112
    v_cvt_pk_bf16_f32 v36, v34, v35
    v_lshlrev_b32 v37, 16, v36
    v_and_b32 v38, 0xffff0000, v36
    v_mul_f32 v37, v37, v116
    v_mul_f32 v38, v38, v116
    v_cvt_pk_bf16_f32 v44, v37, v38
    v_sub_f32 v34, 0x40c00000, v112
    v_sub_f32 v35, 0x40e00000, v112
    v_cvt_pk_bf16_f32 v36, v34, v35
    v_lshlrev_b32 v37, 16, v36
    v_and_b32 v38, 0xffff0000, v36
    v_mul_f32 v37, v37, v116
    v_mul_f32 v38, v38, v116
    v_cvt_pk_bf16_f32 v45, v37, v38
    s_mov_b32 s33, 0x06040200
    s_mov_b32 s31, 0x07050301
    v_perm_b32 v30, v43, v42, s33
    v_perm_b32 v31, v45, v44, s33
    v_perm_b32 v32, v43, v42, s31
    v_perm_b32 v33, v45, v44, s31
    s_waitcnt vmcnt(8)
    v_bfe_u32 v34, v46, 0, 6
    v_bfe_u32 v35, v46, 6, 6
    v_lshl_or_b32 v34, v35, 16, v34
    v_lshl_or_b32 v35, v34, 5, v34
    v_and_b32 v36, 0x07070707, v35
    v_perm_b32 v37, v27, v26, v36
    v_perm_b32 v38, v29, v28, v36
    v_perm_b32 v104, v38, v37, s28
    v_perm_b32 v105, v38, v37, s29
    v_bfe_u32 v34, v46, 12, 6
    v_bfe_u32 v35, v46, 18, 6
    v_lshl_or_b32 v34, v35, 16, v34
    v_lshl_or_b32 v35, v34, 5, v34
    v_and_b32 v36, 0x07070707, v35
    v_perm_b32 v37, v27, v26, v36
    v_perm_b32 v38, v29, v28, v36
    v_perm_b32 v106, v38, v37, s28
    v_perm_b32 v107, v38, v37, s29
    v_bfe_u32 v40, v55, 0, 6
    v_bfe_u32 v41, v55, 6, 6
    v_lshl_or_b32 v40, v41, 16, v40
    v_lshl_or_b32 v41, v40, 5, v40
    v_and_b32 v42, 0x07070707, v41
    v_perm_b32 v43, v31, v30, v42
    v_perm_b32 v44, v33, v32, v42
    v_perm_b32 v108, v44, v43, s28
    v_perm_b32 v109, v44, v43, s29
    v_bfe_u32 v40, v55, 12, 6
    v_bfe_u32 v41, v55, 18, 6
    v_lshl_or_b32 v40, v41, 16, v40
    v_lshl_or_b32 v41, v40, 5, v40
    v_and_b32 v42, 0x07070707, v41
    v_perm_b32 v43, v31, v30, v42
    v_perm_b32 v44, v33, v32, v42
    v_perm_b32 v110, v44, v43, s28
    v_perm_b32 v111, v44, v43, s29
    s_waitcnt vmcnt(5)
    s_barrier
    ds_read_b128 v[64:67], v16 offset:0
    ds_read_b128 v[68:71], v16 offset:5120
    ds_read_b128 v[72:75], v16 offset:10240
    ds_read_b128 v[76:79], v16 offset:15360
    ds_read_b128 v[80:83], v21
    s_mov_b32 s46, 0
L_loopA:
    s_add_u32 s47, s47, 147456
    s_add_u32 s32, s47, 0
    buffer_load_dword v50, v7, s[8:11], s32 offen
    s_add_u32 s32, s47, 18432
    buffer_load_dword v51, v7, s[8:11], s32 offen
    s_add_u32 s32, s47, 36864
    buffer_load_dword v52, v7, s[8:11], s32 offen
    s_add_u32 s32, s47, 55296
    buffer_load_dword v53, v7, s[8:11], s32 offen
    s_add_u32 s32, s47, 0
    buffer_load_dword v59, v8, s[8:11], s32 offen
    s_add_u32 s32, s47, 18432
    buffer_load_dword v60, v8, s[8:11], s32 offen
    s_add_u32 s32, s47, 36864
    buffer_load_dword v61, v8, s[8:11], s32 offen
    s_add_u32 s32, s47, 55296
    buffer_load_dword v62, v8, s[8:11], s32 offen
    s_add_u32 m0, s49, 0
    s_nop 0
    buffer_load_dwordx4 v4, s[4:7], s48 offen lds
    s_add_u32 m0, s49, 8192
    s_nop 0
    buffer_load_dwordx4 v5, s[4:7], s48 offen lds
    s_add_u32 m0, s49, 16384
    s_nop 0
    buffer_load_dwordx4 v6, s[4:7], s48 offen lds
    s_add_u32 s48, s48, 160
    s_min_u32 s48, s48, 1120
    s_add_u32 s49, s49, 20480
    s_min_u32 s49, s49, s30
    ds_read_b128 v[84:87], v17 offset:0
    ds_read_b128 v[88:91], v17 offset:5120
    ds_read_b128 v[92:95], v17 offset:10240
    ds_read_b128 v[96:99], v17 offset:15360
    ds_read_b128 v[100:103], v22
    s_waitcnt lgkmcnt(5)
    v_mfma_f32_32x32x16_bf16 v[120:135], v[104:107], v[64:67], v[120:135]
    v_bfe_u32 v34, v46, 24, 6
    v_bfe_u32 v35, v47, 0, 6
    v_lshl_or_b32 v34, v35, 16, v34
    v_lshl_or_b32 v35, v34, 5, v34
    v_and_b32 v36, 0x07070707, v35
    v_perm_b32 v37, v27, v26, v36
    v_perm_b32 v38, v29, v28, v36
    v_perm_b32 v112, v38, v37, s28
    v_mfma_f32_32x32x16_bf16 v[136:151], v[104:107], v[68:71], v[136:151]
    v_perm_b32 v113, v38, v37, s29
    v_bfe_u32 v34, v47, 6, 6
    v_bfe_u32 v35, v47, 12, 6
    v_lshl_or_b32 v34, v35, 16, v34
    v_lshl_or_b32 v35, v34, 5, v34
    v_and_b32 v36, 0x07070707, v35
    v_perm_b32 v37, v27, v26, v36
    v_perm_b32 v38, v29, v28, v36
    v_mfma_f32_32x32x16_bf16 v[152:167], v[104:107], v[72:75], v[152:167]
    v_perm_b32 v114, v38, v37, s28
    v_perm_b32 v115, v38, v37, s29
    v_bfe_u32 v40, v55, 24, 6
    v_bfe_u32 v41, v56, 0, 6
    v_lshl_or_b32 v40, v41, 16, v40
    v_lshl_or_b32 v41, v40, 5, v40
    v_and_b32 v42, 0x07070707, v41
    v_perm_b32 v43, v31, v30, v42
    v_mfma_f32_32x32x16_bf16 v[168:183], v[104:107], v[76:79], v[168:183]
    v_perm_b32 v44, v33, v32, v42
    v_perm_b32 v116, v44, v43, s28
    v_perm_b32 v117, v44, v43, s29
    v_bfe_u32 v40, v56, 6, 6
    v_bfe_u32 v41, v56, 12, 6
    v_lshl_or_b32 v40, v41, 16, v40
    v_lshl_or_b32 v41, v40, 5, v40
    v_and_b32 v42, 0x07070707, v41
    v_mfma_f32_32x32x16_bf16 v[184:199], v[108:111], v[80:83], v[184:199]
    v_perm_b32 v43, v31, v30, v42
    v_perm_b32 v44, v33, v32, v42
    v_perm_b32 v118, v44, v43, s28
    v_perm_b32 v119, v44, v43, s29
    ds_read_b128 v[64:67], v18 offset:0
    ds_read_b128 v[68:71], v18 offset:5120
    ds_read_b128 v[72:75], v18 offset:10240
    ds_read_b128 v[76:79], v18 offset:15360
    ds_read_b128 v[80:83], v23
    s_waitcnt lgkmcnt(5)
    v_mfma_f32_32x32x16_bf16 v[120:135], v[112:115], v[84:87], v[120:135]
    v_bfe_u32 v34, v47, 18, 6
    v_bfe_u32 v35, v47, 24, 6
    v_lshl_or_b32 v34, v35, 16, v34
    v_lshl_or_b32 v35, v34, 5, v34
    v_and_b32 v36, 0x07070707, v35
    v_perm_b32 v37, v27, v26, v36
    v_perm_b32 v38, v29, v28, v36
    v_perm_b32 v104, v38, v37, s28
    v_mfma_f32_32x32x16_bf16 v[136:151], v[112:115], v[88:91], v[136:151]
    v_perm_b32 v105, v38, v37, s29
    v_bfe_u32 v34, v48, 0, 6
    v_bfe_u32 v35, v48, 6, 6
    v_lshl_or_b32 v34, v35, 16, v34
    v_lshl_or_b32 v35, v34, 5, v34
    v_and_b32 v36, 0x07070707, v35
    v_perm_b32 v37, v27, v26, v36
    v_perm_b32 v38, v29, v28, v36
    v_mfma_f32_32x32x16_bf16 v[152:167], v[112:115], v[92:95], v[152:167]
    v_perm_b32 v106, v38, v37, s28
    v_perm_b32 v107, v38, v37, s29
    v_bfe_u32 v40, v56, 18, 6
    v_bfe_u32 v41, v56, 24, 6
    v_lshl_or_b32 v40, v41, 16, v40
    v_lshl_or_b32 v41, v40, 5, v40
    v_and_b32 v42, 0x07070707, v41
    v_perm_b32 v43, v31, v30, v42
    v_mfma_f32_32x32x16_bf16 v[168:183], v[112:115], v[96:99], v[168:183]
    v_perm_b32 v44, v33, v32, v42
    v_perm_b32 v108, v44, v43, s28
    v_perm_b32 v109, v44, v43, s29
    v_bfe_u32 v40, v57, 0, 6
    v_bfe_u32 v41, v57, 6, 6
    v_lshl_or_b32 v40, v41, 16, v40
    v_lshl_or_b32 v41, v40, 5, v40
    v_and_b32 v42, 0x07070707, v41
    v_mfma_f32_32x32x16_bf16 v[184:199], v[116:119], v[100:103], v[184:199]
    v_perm_b32 v43, v31, v30, v42
    v_perm_b32 v44, v33, v32, v42
    v_perm_b32 v110, v44, v43, s28
    v_perm_b32 v111, v44, v43, s29
    ds_read_b128 v[84:87], v19 offset:0
    ds_read_b128 v[88:91], v19 offset:5120
    ds_read_b128 v[92:95], v19 offset:10240
    ds_read_b128 v[96:99], v19 offset:15360
    ds_read_b128 v[100:103], v24
    s_waitcnt lgkmcnt(5)
    v_mfma_f32_32x32x16_bf16 v[120:135], v[104:107], v[64:67], v[120:135]
    v_bfe_u32 v34, v48, 12, 6
    v_bfe_u32 v35, v48, 18, 6
    v_lshl_or_b32 v34, v35, 16, v34
    v_lshl_or_b32 v35, v34, 5, v34
    v_and_b32 v36, 0x07070707, v35
    v_perm_b32 v37, v27, v26, v36
    v_perm_b32 v38, v29, v28, v36
    v_perm_b32 v112, v38, v37, s28
    v_mfma_f32_32x32x16_bf16 v[136:151], v[104:107], v[68:71], v[136:151]
    v_perm_b32 v113, v38, v37, s29
    v_bfe_u32 v34, v48, 24, 6
    v_bfe_u32 v35, v49, 0, 6
    v_lshl_or_b32 v34, v35, 16, v34
    v_lshl_or_b32 v35, v34, 5, v34
    v_and_b32 v36, 0x07070707, v35
    v_perm_b32 v37, v27, v26, v36
    v_perm_b32 v38, v29, v28, v36
    v_mfma_f32_32x32x16_bf16 v[152:167], v[104:107], v[72:75], v[152:167]
    v_perm_b32 v114, v38, v37, s28
    v_perm_b32 v115, v38, v37, s29
    v_bfe_u32 v40, v57, 12, 6
    v_bfe_u32 v41, v57, 18, 6
    v_lshl_or_b32 v40, v41, 16, v40
    v_lshl_or_b32 v41, v40, 5, v40
    v_and_b32 v42, 0x07070707, v41
    v_perm_b32 v43, v31, v30, v42
    v_mfma_f32_32x32x16_bf16 v[168:183], v[104:107], v[76:79], v[168:183]
    v_perm_b32 v44, v33, v32, v42
    v_perm_b32 v116, v44, v43, s28
    v_perm_b32 v117, v44, v43, s29
    v_bfe_u32 v40, v57, 24, 6
    v_bfe_u32 v41, v58, 0, 6
    v_lshl_or_b32 v40, v41, 16, v40
    v_lshl_or_b32 v41, v40, 5, v40
    v_and_b32 v42, 0x07070707, v41
    v_mfma_f32_32x32x16_bf16 v[184:199], v[108:111], v[80:83], v[184:199]
    v_perm_b32 v43, v31, v30, v42
    v_perm_b32 v44, v33, v32, v42
    v_perm_b32 v118, v44, v43, s28
    v_perm_b32 v119, v44, v43, s29
    ds_read_b128 v[64:67], v20 offset:0
    ds_read_b128 v[68:71], v20 offset:5120
    ds_read_b128 v[72:75], v20 offset:10240
    ds_read_b128 v[76:79], v20 offset:15360
    ds_read_b128 v[80:83], v25
    s_waitcnt lgkmcnt(5)
    v_mfma_f32_32x32x16_bf16 v[120:135], v[112:115], v[84:87], v[120:135]
    v_bfe_u32 v34, v49, 6, 6
    v_bfe_u32 v35, v49, 12, 6
    v_lshl_or_b32 v34, v35, 16, v34
    v_lshl_or_b32 v35, v34, 5, v34
    v_and_b32 v36, 0x07070707, v35
    v_perm_b32 v37, v27, v26, v36
    v_perm_b32 v38, v29, v28, v36
    v_perm_b32 v104, v38, v37, s28
    v_mfma_f32_32x32x16_bf16 v[136:151], v[112:115], v[88:91], v[136:151]
    v_perm_b32 v105, v38, v37, s29
    v_bfe_u32 v34, v49, 18, 6
    v_bfe_u32 v35, v49, 24, 6
    v_lshl_or_b32 v34, v35, 16, v34
    v_lshl_or_b32 v35, v34, 5, v34
    v_and_b32 v36, 0x07070707, v35
    v_perm_b32 v37, v27, v26, v36
    v_perm_b32 v38, v29, v28, v36
    v_mfma_f32_32x32x16_bf16 v[152:167], v[112:115], v[92:95], v[152:167]
    v_perm_b32 v106, v38, v37, s28
    v_perm_b32 v107, v38, v37, s29
    v_bfe_u32 v40, v58, 6, 6
    v_bfe_u32 v41, v58, 12, 6
    v_lshl_or_b32 v40, v41, 16, v40
    v_lshl_or_b32 v41, v40, 5, v40
    v_and_b32 v42, 0x07070707, v41
    v_perm_b32 v43, v31, v30, v42
    v_mfma_f32_32x32x16_bf16 v[168:183], v[112:115], v[96:99], v[168:183]
    v_perm_b32 v44, v33, v32, v42
    v_perm_b32 v108, v44, v43, s28
    v_perm_b32 v109, v44, v43, s29
    v_bfe_u32 v40, v58, 18, 6
    v_bfe_u32 v41, v58, 24, 6
    v_lshl_or_b32 v40, v41, 16, v40
    v_lshl_or_b32 v41, v40, 5, v40
    v_and_b32 v42, 0x07070707, v41
    v_mfma_f32_32x32x16_bf16 v[184:199], v[116:119], v[100:103], v[184:199]
    v_perm_b32 v43, v31, v30, v42
    v_perm_b32 v44, v33, v32, v42
    v_perm_b32 v110, v44, v43, s28
    v_perm_b32 v111, v44, v43, s29
    s_waitcnt vmcnt(3)
    s_barrier
    v_add_u32 v16, 20480, v16
    v_add_u32 v21, 20480, v21
    v_add_u32 v17, 20480, v17
    v_add_u32 v22, 20480, v22
    v_add_u32 v18, 20480, v18
    v_add_u32 v23, 20480, v23
    v_add_u32 v19, 20480, v19
    v_add_u32 v24, 20480, v24
    v_add_u32 v20, 20480, v20
    v_add_u32 v25, 20480, v25
    ds_read_b128 v[84:87], v16 offset:0
    ds_read_b128 v[88:91], v16 offset:5120
    ds_read_b128 v[92:95], v16 offset:10240
    ds_read_b128 v[96:99], v16 offset:15360
    ds_read_b128 v[100:103], v21
    s_waitcnt lgkmcnt(5)
    v_mfma_f32_32x32x16_bf16 v[120:135], v[104:107], v[64:67], v[120:135]
    v_bfe_u32 v34, v50, 0, 6
    v_bfe_u32 v35, v50, 6, 6
    v_lshl_or_b32 v34, v35, 16, v34
    v_lshl_or_b32 v35, v34, 5, v34
    v_and_b32 v36, 0x07070707, v35
    v_perm_b32 v37, v27, v26, v36
    v_perm_b32 v38, v29, v28, v36
    v_perm_b32 v112, v38, v37, s28
    v_mfma_f32_32x32x16_bf16 v[136:151], v[104:107], v[68:71], v[136:151]
    v_perm_b32 v113, v38, v37, s29
    v_bfe_u32 v34, v50, 12, 6
    v_bfe_u32 v35, v50, 18, 6
    v_lshl_or_b32 v34, v35, 16, v34
    v_lshl_or_b32 v35, v34, 5, v34
    v_and_b32 v36, 0x07070707, v35
    v_perm_b32 v37, v27, v26, v36
    v_perm_b32 v38, v29, v28, v36
    v_mfma_f32_32x32x16_bf16 v[152:167], v[104:107], v[72:75], v[152:167]
    v_perm_b32 v114, v38, v37, s28
    v_perm_b32 v115, v38, v37, s29
    v_bfe_u32 v40, v59, 0, 6
    v_bfe_u32 v41, v59, 6, 6
    v_lshl_or_b32 v40, v41, 16, v40
    v_lshl_or_b32 v41, v40, 5, v40
    v_and_b32 v42, 0x07070707, v41
    v_perm_b32 v43, v31, v30, v42
    v_mfma_f32_32x32x16_bf16 v[168:183], v[104:107], v[76:79], v[168:183]
    v_perm_b32 v44, v33, v32, v42
    v_perm_b32 v116, v44, v43, s28
    v_perm_b32 v117, v44, v43, s29
    v_bfe_u32 v40, v59, 12, 6
    v_bfe_u32 v41, v59, 18, 6
    v_lshl_or_b32 v40, v41, 16, v40
    v_lshl_or_b32 v41, v40, 5, v40
    v_and_b32 v42, 0x07070707, v41
    v_mfma_f32_32x32x16_bf16 v[184:199], v[108:111], v[80:83], v[184:199]
    v_perm_b32 v43, v31, v30, v42
    v_perm_b32 v44, v33, v32, v42
    v_perm_b32 v118, v44, v43, s28
    v_perm_b32 v119, v44, v43, s29
    s_add_u32 s46, s46, 1
    s_cmp_eq_u32 s46, 7
    s_cbranch_scc1 L_doneA0
    s_add_u32 s47, s47, 147456
    s_add_u32 s32, s47, 0
    buffer_load_dword v46, v7, s[8:11], s32 offen
    s_add_u32 s32, s47, 18432
    buffer_load_dword v47, v7, s[8:11], s32 offen
    s_add_u32 s32, s47, 36864
    buffer_load_dword v48, v7, s[8:11], s32 offen
    s_add_u32 s32, s47, 55296
    buffer_load_dword v49, v7, s[8:11], s32 offen
    s_add_u32 s32, s47, 0
    buffer_load_dword v55, v8, s[8:11], s32 offen
    s_add_u32 s32, s47, 18432
    buffer_load_dword v56, v8, s[8:11], s32 offen
    s_add_u32 s32, s47, 36864
    buffer_load_dword v57, v8, s[8:11], s32 offen
    s_add_u32 s32, s47, 55296
    buffer_load_dword v58, v8, s[8:11], s32 offen
    s_add_u32 m0, s49, 0
    s_nop 0
    buffer_load_dwordx4 v4, s[4:7], s48 offen lds
    s_add_u32 m0, s49, 8192
    s_nop 0
    buffer_load_dwordx4 v5, s[4:7], s48 offen lds
    s_add_u32 m0, s49, 16384
    s_nop 0
    buffer_load_dwordx4 v6, s[4:7], s48 offen lds
    s_add_u32 s48, s48, 160
    s_min_u32 s48, s48, 1120
    s_add_u32 s49, s49, 20480
    s_min_u32 s49, s49, s30
    ds_read_b128 v[64:67], v17 offset:0
    ds_read_b128 v[68:71], v17 offset:5120
    ds_read_b128 v[72:75], v17 offset:10240
    ds_read_b128 v[76:79], v17 offset:15360
    ds_read_b128 v[80:83], v22
    s_waitcnt lgkmcnt(5)
    v_mfma_f32_32x32x16_bf16 v[120:135], v[112:115], v[84:87], v[120:135]
    v_bfe_u32 v34, v50, 24, 6
    v_bfe_u32 v35, v51, 0, 6
    v_lshl_or_b32 v34, v35, 16, v34
    v_lshl_or_b32 v35, v34, 5, v34
    v_and_b32 v36, 0x07070707, v35
    v_perm_b32 v37, v27, v26, v36
    v_perm_b32 v38, v29, v28, v36
    v_perm_b32 v104, v38, v37, s28
    v_mfma_f32_32x32x16_bf16 v[136:151], v[112:115], v[88:91], v[136:151]
    v_perm_b32 v105, v38, v37, s29
    v_bfe_u32 v34, v51, 6, 6
    v_bfe_u32 v35, v51, 12, 6
    v_lshl_or_b32 v34, v35, 16, v34
    v_lshl_or_b32 v35, v34, 5, v34
    v_and_b32 v36, 0x07070707, v35
    v_perm_b32 v37, v27, v26, v36
    v_perm_b32 v38, v29, v28, v36
    v_mfma_f32_32x32x16_bf16 v[152:167], v[112:115], v[92:95], v[152:167]
    v_perm_b32 v106, v38, v37, s28
    v_perm_b32 v107, v38, v37, s29
    v_bfe_u32 v40, v59, 24, 6
    v_bfe_u32 v41, v60, 0, 6
    v_lshl_or_b32 v40, v41, 16, v40
    v_lshl_or_b32 v41, v40, 5, v40
    v_and_b32 v42, 0x07070707, v41
    v_perm_b32 v43, v31, v30, v42
    v_mfma_f32_32x32x16_bf16 v[168:183], v[112:115], v[96:99], v[168:183]
    v_perm_b32 v44, v33, v32, v42
    v_perm_b32 v108, v44, v43, s28
    v_perm_b32 v109, v44, v43, s29
    v_bfe_u32 v40, v60, 6, 6
    v_bfe_u32 v41, v60, 12, 6
    v_lshl_or_b32 v40, v41, 16, v40
    v_lshl_or_b32 v41, v40, 5, v40
    v_and_b32 v42, 0x07070707, v41
    v_mfma_f32_32x32x16_bf16 v[184:199], v[116:119], v[100:103], v[184:199]
    v_perm_b32 v43, v31, v30, v42
    v_perm_b32 v44, v33, v32, v42
    v_perm_b32 v110, v44, v43, s28
    v_perm_b32 v111, v44, v43, s29
    ds_read_b128 v[84:87], v18 offset:0
    ds_read_b128 v[88:91], v18 offset:5120
    ds_read_b128 v[92:95], v18 offset:10240
    ds_read_b128 v[96:99], v18 offset:15360
    ds_read_b128 v[100:103], v23
    s_waitcnt lgkmcnt(5)
    v_mfma_f32_32x32x16_bf16 v[120:135], v[104:107], v[64:67], v[120:135]
    v_bfe_u32 v34, v51, 18, 6
    v_bfe_u32 v35, v51, 24, 6
    v_lshl_or_b32 v34, v35, 16, v34
    v_lshl_or_b32 v35, v34, 5, v34
    v_and_b32 v36, 0x07070707, v35
    v_perm_b32 v37, v27, v26, v36
    v_perm_b32 v38, v29, v28, v36
    v_perm_b32 v112, v38, v37, s28
    v_mfma_f32_32x32x16_bf16 v[136:151], v[104:107], v[68:71], v[136:151]
    v_perm_b32 v113, v38, v37, s29
    v_bfe_u32 v34, v52, 0, 6
    v_bfe_u32 v35, v52, 6, 6
    v_lshl_or_b32 v34, v35, 16, v34
    v_lshl_or_b32 v35, v34, 5, v34
    v_and_b32 v36, 0x07070707, v35
    v_perm_b32 v37, v27, v26, v36
    v_perm_b32 v38, v29, v28, v36
    v_mfma_f32_32x32x16_bf16 v[152:167], v[104:107], v[72:75], v[152:167]
    v_perm_b32 v114, v38, v37, s28
    v_perm_b32 v115, v38, v37, s29
    v_bfe_u32 v40, v60, 18, 6
    v_bfe_u32 v41, v60, 24, 6
    v_lshl_or_b32 v40, v41, 16, v40
    v_lshl_or_b32 v41, v40, 5, v40
    v_and_b32 v42, 0x07070707, v41
    v_perm_b32 v43, v31, v30, v42
    v_mfma_f32_32x32x16_bf16 v[168:183], v[104:107], v[76:79], v[168:183]
    v_perm_b32 v44, v33, v32, v42
    v_perm_b32 v116, v44, v43, s28
    v_perm_b32 v117, v44, v43, s29
    v_bfe_u32 v40, v61, 0, 6
    v_bfe_u32 v41, v61, 6, 6
    v_lshl_or_b32 v40, v41, 16, v40
    v_lshl_or_b32 v41, v40, 5, v40
    v_and_b32 v42, 0x07070707, v41
    v_mfma_f32_32x32x16_bf16 v[184:199], v[108:111], v[80:83], v[184:199]
    v_perm_b32 v43, v31, v30, v42
    v_perm_b32 v44, v33, v32, v42
    v_perm_b32 v118, v44, v43, s28
    v_perm_b32 v119, v44, v43, s29
    ds_read_b128 v[64:67], v19 offset:0
    ds_read_b128 v[68:71], v19 offset:5120
    ds_read_b128 v[72:75], v19 offset:10240
    ds_read_b128 v[76:79], v19 offset:15360
    ds_read_b128 v[80:83], v24
    s_waitcnt lgkmcnt(5)
    v_mfma_f32_32x32x16_bf16 v[120:135], v[112:115], v[84:87], v[120:135]
    v_bfe_u32 v34, v52, 12, 6
    v_bfe_u32 v35, v52, 18, 6
    v_lshl_or_b32 v34, v35, 16, v34
    v_lshl_or_b32 v35, v34, 5, v34
    v_and_b32 v36, 0x07070707, v35
    v_perm_b32 v37, v27, v26, v36
    v_perm_b32 v38, v29, v28, v36
    v_perm_b32 v104, v38, v37, s28
    v_mfma_f32_32x32x16_bf16 v[136:151], v[112:115], v[88:91], v[136:151]
    v_perm_b32 v105, v38, v37, s29
    v_bfe_u32 v34, v52, 24, 6
    v_bfe_u32 v35, v53, 0, 6
    v_lshl_or_b32 v34, v35, 16, v34
    v_lshl_or_b32 v35, v34, 5, v34
    v_and_b32 v36, 0x07070707, v35
    v_perm_b32 v37, v27, v26, v36
    v_perm_b32 v38, v29, v28, v36
    v_mfma_f32_32x32x16_bf16 v[152:167], v[112:115], v[92:95], v[152:167]
    v_perm_b32 v106, v38, v37, s28
    v_perm_b32 v107, v38, v37, s29
    v_bfe_u32 v40, v61, 12, 6
    v_bfe_u32 v41, v61, 18, 6
    v_lshl_or_b32 v40, v41, 16, v40
    v_lshl_or_b32 v41, v40, 5, v40
    v_and_b32 v42, 0x07070707, v41
    v_perm_b32 v43, v31, v30, v42
    v_mfma_f32_32x32x16_bf16 v[168:183], v[112:115], v[96:99], v[168:183]
    v_perm_b32 v44, v33, v32, v42
    v_perm_b32 v108, v44, v43, s28
    v_perm_b32 v109, v44, v43, s29
    v_bfe_u32 v40, v61, 24, 6
    v_bfe_u32 v41, v62, 0, 6
    v_lshl_or_b32 v40, v41, 16, v40
    v_lshl_or_b32 v41, v40, 5, v40
    v_and_b32 v42, 0x07070707, v41
    v_mfma_f32_32x32x16_bf16 v[184:199], v[116:119], v[100:103], v[184:199]
    v_perm_b32 v43, v31, v30, v42
    v_perm_b32 v44, v33, v32, v42
    v_perm_b32 v110, v44, v43, s28
    v_perm_b32 v111, v44, v43, s29
    ds_read_b128 v[84:87], v20 offset:0
    ds_read_b128 v[88:91], v20 offset:5120
    ds_read_b128 v[92:95], v20 offset:10240
    ds_read_b128 v[96:99], v20 offset:15360
    ds_read_b128 v[100:103], v25
    s_waitcnt lgkmcnt(5)
    v_mfma_f32_32x32x16_bf16 v[120:135], v[104:107], v[64:67], v[120:135]
    v_bfe_u32 v34, v53, 6, 6
    v_bfe_u32 v35, v53, 12, 6
    v_lshl_or_b32 v34, v35, 16, v34
    v_lshl_or_b32 v35, v34, 5, v34
    v_and_b32 v36, 0x07070707, v35
    v_perm_b32 v37, v27, v26, v36
    v_perm_b32 v38, v29, v28, v36
    v_perm_b32 v112, v38, v37, s28
    v_mfma_f32_32x32x16_bf16 v[136:151], v[104:107], v[68:71], v[136:151]
    v_perm_b32 v113, v38, v37, s29
    v_bfe_u32 v34, v53, 18, 6
    v_bfe_u32 v35, v53, 24, 6
    v_lshl_or_b32 v34, v35, 16, v34
    v_lshl_or_b32 v35, v34, 5, v34
    v_and_b32 v36, 0x07070707, v35
    v_perm_b32 v37, v27, v26, v36
    v_perm_b32 v38, v29, v28, v36
    v_mfma_f32_32x32x16_bf16 v[152:167], v[104:107], v[72:75], v[152:167]
    v_perm_b32 v114, v38, v37, s28
    v_perm_b32 v115, v38, v37, s29
    v_bfe_u32 v40, v62, 6, 6
    v_bfe_u32 v41, v62, 12, 6
    v_lshl_or_b32 v40, v41, 16, v40
    v_lshl_or_b32 v41, v40, 5, v40
    v_and_b32 v42, 0x07070707, v41
    v_perm_b32 v43, v31, v30, v42
    v_mfma_f32_32x32x16_bf16 v[168:183], v[104:107], v[76:79], v[168:183]
    v_perm_b32 v44, v33, v32, v42
    v_perm_b32 v116, v44, v43, s28
    v_perm_b32 v117, v44, v43, s29
    v_bfe_u32 v40, v62, 18, 6
    v_bfe_u32 v41, v62, 24, 6
    v_lshl_or_b32 v40, v41, 16, v40
    v_lshl_or_b32 v41, v40, 5, v40
    v_and_b32 v42, 0x07070707, v41
    v_mfma_f32_32x32x16_bf16 v[184:199], v[108:111], v[80:83], v[184:199]
    v_perm_b32 v43, v31, v30, v42
    v_perm_b32 v44, v33, v32, v42
    v_perm_b32 v118, v44, v43, s28
    v_perm_b32 v119, v44, v43, s29
    s_waitcnt vmcnt(3)
    s_barrier
    v_add_u32 v16, 20480, v16
    v_add_u32 v21, 20480, v21
    v_add_u32 v17, 20480, v17
    v_add_u32 v22, 20480, v22
    v_add_u32 v18, 20480, v18
    v_add_u32 v23, 20480, v23
    v_add_u32 v19, 20480, v19
    v_add_u32 v24, 20480, v24
    v_add_u32 v20, 20480, v20
    v_add_u32 v25, 20480, v25
    ds_read_b128 v[64:67], v16 offset:0
    ds_read_b128 v[68:71], v16 offset:5120
    ds_read_b128 v[72:75], v16 offset:10240
    ds_read_b128 v[76:79], v16 offset:15360
    ds_read_b128 v[80:83], v21
    s_waitcnt lgkmcnt(5)
    v_mfma_f32_32x32x16_bf16 v[120:135], v[112:115], v[84:87], v[120:135]
    v_bfe_u32 v34, v46, 0, 6
    v_bfe_u32 v35, v46, 6, 6
    v_lshl_or_b32 v34, v35, 16, v34
    v_lshl_or_b32 v35, v34, 5, v34
    v_and_b32 v36, 0x07070707, v35
    v_perm_b32 v37, v27, v26, v36
    v_perm_b32 v38, v29, v28, v36
    v_perm_b32 v104, v38, v37, s28
    v_mfma_f32_32x32x16_bf16 v[136:151], v[112:115], v[88:91], v[136:151]
    v_perm_b32 v105, v38, v37, s29
    v_bfe_u32 v34, v46, 12, 6
    v_bfe_u32 v35, v46, 18, 6
    v_lshl_or_b32 v34, v35, 16, v34
    v_lshl_or_b32 v35, v34, 5, v34
    v_and_b32 v36, 0x07070707, v35
    v_perm_b32 v37, v27, v26, v36
    v_perm_b32 v38, v29, v28, v36
    v_mfma_f32_32x32x16_bf16 v[152:167], v[112:115], v[92:95], v[152:167]
    v_perm_b32 v106, v38, v37, s28
    v_perm_b32 v107, v38, v37, s29
    v_bfe_u32 v40, v55, 0, 6
    v_bfe_u32 v41, v55, 6, 6
    v_lshl_or_b32 v40, v41, 16, v40
    v_lshl_or_b32 v41, v40, 5, v40
    v_and_b32 v42, 0x07070707, v41
    v_perm_b32 v43, v31, v30, v42
    v_mfma_f32_32x32x16_bf16 v[168:183], v[112:115], v[96:99], v[168:183]
    v_perm_b32 v44, v33, v32, v42
    v_perm_b32 v108, v44, v43, s28
    v_perm_b32 v109, v44, v43, s29
    v_bfe_u32 v40, v55, 12, 6
    v_bfe_u32 v41, v55, 18, 6
    v_lshl_or_b32 v40, v41, 16, v40
    v_lshl_or_b32 v41, v40, 5, v40
    v_and_b32 v42, 0x07070707, v41
    v_mfma_f32_32x32x16_bf16 v[184:199], v[116:119], v[100:103], v[184:199]
    v_perm_b32 v43, v31, v30, v42
    v_perm_b32 v44, v33, v32, v42
    v_perm_b32 v110, v44, v43, s28
    v_perm_b32 v111, v44, v43, s29
    s_add_u32 s46, s46, 1
    s_cmp_eq_u32 s46, 7
    s_cbranch_scc1 L_doneA1
    s_branch L_loopA
L_doneA1:
    s_endpgm
L_doneA0:
    s_waitcnt lgkmcnt(0)
    ds_read_b128 v[84:87], v14 offset:0
    ds_read_b128 v[88:91], v14 offset:5120
    ds_read_b128 v[92:95], v14 offset:10240
    ds_read_b128 v[96:99], v14 offset:15360
    ds_read_b128 v[100:103], v15
    v_lshrrev_b32 v39, v12, v54
    v_bfe_u32 v34, v39, 0, 6
    v_bfe_u32 v35, v39, 6, 6
    v_lshl_or_b32 v34, v35, 16, v34
    v_lshl_or_b32 v35, v34, 5, v34
    v_and_b32 v36, 0x07070707, v35
    v_perm_b32 v37, v27, v26, v36
    v_perm_b32 v38, v29, v28, v36
    v_perm_b32 v112, v38, v37, s28
    v_perm_b32 v113, v38, v37, s29
    v_bfe_u32 v34, v39, 12, 6
    v_bfe_u32 v35, v39, 18, 6
    v_lshl_or_b32 v34, v35, 16, v34
    v_lshl_or_b32 v35, v34, 5, v34
    v_and_b32 v36, 0x07070707, v35
    v_perm_b32 v37, v27, v26, v36
    v_perm_b32 v38, v29, v28, v36
    v_perm_b32 v114, v38, v37, s28
    v_perm_b32 v115, v38, v37, s29
    v_and_b32 v113, v13, v113
    v_and_b32 v114, v13, v114
    v_and_b32 v115, v13, v115
    v_lshrrev_b32 v45, v12, v63
    v_bfe_u32 v40, v45, 0, 6
    v_bfe_u32 v41, v45, 6, 6
    v_lshl_or_b32 v40, v41, 16, v40
    v_lshl_or_b32 v41, v40, 5, v40
    v_and_b32 v42, 0x07070707, v41
    v_perm_b32 v43, v31, v30, v42
    v_perm_b32 v44, v33, v32, v42
    v_perm_b32 v116, v44, v43, s28
    v_perm_b32 v117, v44, v43, s29
    v_bfe_u32 v40, v45, 12, 6
    v_bfe_u32 v41, v45, 18, 6
    v_lshl_or_b32 v40, v41, 16, v40
    v_lshl_or_b32 v41, v40, 5, v40
    v_and_b32 v42, 0x07070707, v41
    v_perm_b32 v43, v31, v30, v42
    v_perm_b32 v44, v33, v32, v42
    v_perm_b32 v118, v44, v43, s28
    v_perm_b32 v119, v44, v43, s29
    v_and_b32 v117, v13, v117
    v_and_b32 v118, v13, v118
    v_and_b32 v119, v13, v119
    s_waitcnt lgkmcnt(0)
    s_nop 1
    v_mfma_f32_32x32x16_bf16 v[120:135], v[112:115], v[84:87], v[120:135]
    v_mfma_f32_32x32x16_bf16 v[136:151], v[112:115], v[88:91], v[136:151]
    v_mfma_f32_32x32x16_bf16 v[152:167], v[112:115], v[92:95], v[152:167]
    v_mfma_f32_32x32x16_bf16 v[168:183], v[112:115], v[96:99], v[168:183]
    v_mfma_f32_32x32x16_bf16 v[184:199], v[116:119], v[100:103], v[184:199]
    s_nop 15
    s_nop 7
    v_cvt_pk_bf16_f32 v64, v120, v121
    v_cvt_pk_bf16_f32 v65, v122, v123
    v_cvt_pk_bf16_f32 v66, v124, v125
    v_cvt_pk_bf16_f32 v67, v126, v127
    v_cvt_pk_bf16_f32 v68, v128, v129
    v_cvt_pk_bf16_f32 v69, v130, v131
    v_cvt_pk_bf16_f32 v70, v132, v133
    v_cvt_pk_bf16_f32 v71, v134, v135
    v_permlane32_swap_b32 v64, v66
    v_permlane32_swap_b32 v65, v67
    v_permlane32_swap_b32 v68, v70
    v_permlane32_swap_b32 v69, v71
    s_mov_b32 s32, 0
    buffer_store_dwordx4 v[64:67], v11, s[20:23], s32 offen offset:0
    buffer_store_dwordx4 v[68:71], v11, s[20:23], s32 offen offset:32
    v_cvt_pk_bf16_f32 v72, v136, v137
    v_cvt_pk_bf16_f32 v73, v138, v139
    v_cvt_pk_bf16_f32 v74, v140, v141
    v_cvt_pk_bf16_f32 v75, v142, v143
    v_cvt_pk_bf16_f32 v76, v144, v145
    v_cvt_pk_bf16_f32 v77, v146, v147
    v_cvt_pk_bf16_f32 v78, v148, v149
    v_cvt_pk_bf16_f32 v79, v150, v151
    v_permlane32_swap_b32 v72, v74
    v_permlane32_swap_b32 v73, v75
    v_permlane32_swap_b32 v76, v78
    v_permlane32_swap_b32 v77, v79
    s_mov_b32 s32, 294912
    buffer_store_dwordx4 v[72:75], v11, s[20:23], s32 offen offset:0
    buffer_store_dwordx4 v[76:79], v11, s[20:23], s32 offen offset:32
    v_cvt_pk_bf16_f32 v84, v152, v153
    v_cvt_pk_bf16_f32 v85, v154, v155
    v_cvt_pk_bf16_f32 v86, v156, v157
    v_cvt_pk_bf16_f32 v87, v158, v159
    v_cvt_pk_bf16_f32 v88, v160, v161
    v_cvt_pk_bf16_f32 v89, v162, v163
    v_cvt_pk_bf16_f32 v90, v164, v165
    v_cvt_pk_bf16_f32 v91, v166, v167
    v_permlane32_swap_b32 v84, v86
    v_permlane32_swap_b32 v85, v87
    v_permlane32_swap_b32 v88, v90
    v_permlane32_swap_b32 v89, v91
    s_mov_b32 s32, 589824
    buffer_store_dwordx4 v[84:87], v11, s[20:23], s32 offen offset:0
    buffer_store_dwordx4 v[88:91], v11, s[20:23], s32 offen offset:32
    v_cvt_pk_bf16_f32 v92, v168, v169
    v_cvt_pk_bf16_f32 v93, v170, v171
    v_cvt_pk_bf16_f32 v94, v172, v173
    v_cvt_pk_bf16_f32 v95, v174, v175
    v_cvt_pk_bf16_f32 v96, v176, v177
    v_cvt_pk_bf16_f32 v97, v178, v179
    v_cvt_pk_bf16_f32 v98, v180, v181
    v_cvt_pk_bf16_f32 v99, v182, v183
    v_permlane32_swap_b32 v92, v94
    v_permlane32_swap_b32 v93, v95
    v_permlane32_swap_b32 v96, v98
    v_permlane32_swap_b32 v97, v99
    s_mov_b32 s32, 884736
    buffer_store_dwordx4 v[92:95], v11, s[20:23], s32 offen offset:0
    buffer_store_dwordx4 v[96:99], v11, s[20:23], s32 offen offset:32
    v_cvt_pk_bf16_f32 v64, v184, v185
    v_cvt_pk_bf16_f32 v65, v186, v187
    v_cvt_pk_bf16_f32 v66, v188, v189
    v_cvt_pk_bf16_f32 v67, v190, v191
    v_cvt_pk_bf16_f32 v68, v192, v193
    v_cvt_pk_bf16_f32 v69, v194, v195
    v_cvt_pk_bf16_f32 v70, v196, v197
    v_cvt_pk_bf16_f32 v71, v198, v199
    v_permlane32_swap_b32 v64, v66
    v_permlane32_swap_b32 v65, v67
    v_permlane32_swap_b32 v68, v70
    v_permlane32_swap_b32 v69, v71
    s_mul_i32 s33, s24, 294848
    s_add_u32 s33, s33, 512
    buffer_store_dwordx4 v[64:67], v11, s[20:23], s33 offen offset:0
    buffer_store_dwordx4 v[68:71], v11, s[20:23], s33 offen offset:32
    s_endpgm
L_bwave:
    v_mov_b32 v120, 0
    v_mov_b32 v121, 0
    v_mov_b32 v122, 0
    v_mov_b32 v123, 0
    v_mov_b32 v124, 0
    v_mov_b32 v125, 0
    v_mov_b32 v126, 0
    v_mov_b32 v127, 0
    v_mov_b32 v128, 0
    v_mov_b32 v129, 0
    v_mov_b32 v130, 0
    v_mov_b32 v131, 0
    v_mov_b32 v132, 0
    v_mov_b32 v133, 0
    v_mov_b32 v134, 0
    v_mov_b32 v135, 0
    v_mov_b32 v136, 0
    v_mov_b32 v137, 0
    v_mov_b32 v138, 0
    v_mov_b32 v139, 0
    v_mov_b32 v140, 0
    v_mov_b32 v141, 0
    v_mov_b32 v142, 0
    v_mov_b32 v143, 0
    v_mov_b32 v144, 0
    v_mov_b32 v145, 0
    v_mov_b32 v146, 0
    v_mov_b32 v147, 0
    v_mov_b32 v148, 0
    v_mov_b32 v149, 0
    v_mov_b32 v150, 0
    v_mov_b32 v151, 0
    v_mov_b32 v152, 0
    v_mov_b32 v153, 0
    v_mov_b32 v154, 0
    v_mov_b32 v155, 0
    v_mov_b32 v156, 0
    v_mov_b32 v157, 0
    v_mov_b32 v158, 0
    v_mov_b32 v159, 0
    v_mov_b32 v160, 0
    v_mov_b32 v161, 0
    v_mov_b32 v162, 0
    v_mov_b32 v163, 0
    v_mov_b32 v164, 0
    v_mov_b32 v165, 0
    v_mov_b32 v166, 0
    v_mov_b32 v167, 0
    v_mov_b32 v168, 0
    v_mov_b32 v169, 0
    v_mov_b32 v170, 0
    v_mov_b32 v171, 0
    v_mov_b32 v172, 0
    v_mov_b32 v173, 0
    v_mov_b32 v174, 0
    v_mov_b32 v175, 0
    v_mov_b32 v176, 0
    v_mov_b32 v177, 0
    v_mov_b32 v178, 0
    v_mov_b32 v179, 0
    v_mov_b32 v180, 0
    v_mov_b32 v181, 0
    v_mov_b32 v182, 0
    v_mov_b32 v183, 0
    s_add_u32 s30, s27, 143360
    v_lshrrev_b32 v34, 1, v9
    buffer_load_ushort v40, v34, s[16:19], 0 offen
    buffer_load_ushort v41, v34, s[12:15], 0 offen
    s_mov_b32 s47, 0
    s_mov_b32 s48, 0
    s_mov_b32 s49, s27
    s_add_u32 s32, s47, 0
    buffer_load_dword v46, v7, s[8:11], s32 offen
    s_add_u32 s32, s47, 18432
    buffer_load_dword v47, v7, s[8:11], s32 offen
    s_add_u32 s32, s47, 36864
    buffer_load_dword v48, v7, s[8:11], s32 offen
    s_add_u32 s32, s47, 55296
    buffer_load_dword v49, v7, s[8:11], s32 offen
    s_add_u32 m0, s49, 0
    s_nop 0
    buffer_load_dwordx4 v4, s[4:7], s48 offen lds
    s_add_u32 m0, s49, 8192
    s_nop 0
    buffer_load_dwordx4 v5, s[4:7], s48 offen lds
    s_add_u32 s48, s48, 160
    s_min_u32 s48, s48, 1120
    s_add_u32 s49, s49, 20480
    s_min_u32 s49, s49, s30
    s_mov_b32 s32, 1032192
    buffer_load_dword v54, v9, s[8:11], s32 offen
    s_add_u32 m0, s49, 0
    s_nop 0
    buffer_load_dwordx4 v4, s[4:7], s48 offen lds
    s_add_u32 m0, s49, 8192
    s_nop 0
    buffer_load_dwordx4 v5, s[4:7], s48 offen lds
    s_add_u32 s48, s48, 160
    s_min_u32 s48, s48, 1120
    s_add_u32 s49, s49, 20480
    s_min_u32 s49, s49, s30
    s_waitcnt vmcnt(9)
    v_lshlrev_b32 v40, 16, v40
    v_lshlrev_b32 v41, 16, v41
    v_sub_f32 v34, 0, v40
    v_sub_f32 v35, 1.0, v40
    v_cvt_pk_bf16_f32 v36, v34, v35
    v_lshlrev_b32 v37, 16, v36
    v_and_b32 v38, 0xffff0000, v36
    v_mul_f32 v37, v37, v41
    v_mul_f32 v38, v38, v41
    v_cvt_pk_bf16_f32 v42, v37, v38
    v_sub_f32 v34, 2.0, v40
    v_sub_f32 v35, 0x40400000, v40
    v_cvt_pk_bf16_f32 v36, v34, v35
    v_lshlrev_b32 v37, 16, v36
    v_and_b32 v38, 0xffff0000, v36
    v_mul_f32 v37, v37, v41
    v_mul_f32 v38, v38, v41
    v_cvt_pk_bf16_f32 v43, v37, v38
    v_sub_f32 v34, 4.0, v40
    v_sub_f32 v35, 0x40a00000, v40
    v_cvt_pk_bf16_f32 v36, v34, v35
    v_lshlrev_b32 v37, 16, v36
    v_and_b32 v38, 0xffff0000, v36
    v_mul_f32 v37, v37, v41
    v_mul_f32 v38, v38, v41
    v_cvt_pk_bf16_f32 v44, v37, v38
    v_sub_f32 v34, 0x40c00000, v40
    v_sub_f32 v35, 0x40e00000, v40
    v_cvt_pk_bf16_f32 v36, v34, v35
    v_lshlrev_b32 v37, 16, v36
    v_and_b32 v38, 0xffff0000, v36
    v_mul_f32 v37, v37, v41
    v_mul_f32 v38, v38, v41
    v_cvt_pk_bf16_f32 v45, v37, v38
    s_mov_b32 s33, 0x06040200
    s_mov_b32 s31, 0x07050301
    v_perm_b32 v26, v43, v42, s33
    v_perm_b32 v27, v45, v44, s33
    v_perm_b32 v28, v43, v42, s31
    v_perm_b32 v29, v45, v44, s31
    s_waitcnt vmcnt(5)
    v_bfe_u32 v34, v46, 0, 6
    v_bfe_u32 v35, v46, 6, 6
    v_lshl_or_b32 v34, v35, 16, v34
    v_lshl_or_b32 v35, v34, 5, v34
    v_and_b32 v36, 0x07070707, v35
    v_perm_b32 v37, v27, v26, v36
    v_perm_b32 v38, v29, v28, v36
    v_perm_b32 v104, v38, v37, s28
    v_perm_b32 v105, v38, v37, s29
    v_bfe_u32 v34, v46, 12, 6
    v_bfe_u32 v35, v46, 18, 6
    v_lshl_or_b32 v34, v35, 16, v34
    v_lshl_or_b32 v35, v34, 5, v34
    v_and_b32 v36, 0x07070707, v35
    v_perm_b32 v37, v27, v26, v36
    v_perm_b32 v38, v29, v28, v36
    v_perm_b32 v106, v38, v37, s28
    v_perm_b32 v107, v38, v37, s29
    s_waitcnt vmcnt(3)
    s_barrier
    ds_read_b128 v[64:67], v16 offset:0
    ds_read_b128 v[68:71], v16 offset:5120
    ds_read_b128 v[72:75], v16 offset:10240
    ds_read_b128 v[76:79], v16 offset:15360
    s_mov_b32 s46, 0
L_loopB:
    s_add_u32 s47, s47, 147456
    s_add_u32 s32, s47, 0
    buffer_load_dword v50, v7, s[8:11], s32 offen
    s_add_u32 s32, s47, 18432
    buffer_load_dword v51, v7, s[8:11], s32 offen
    s_add_u32 s32, s47, 36864
    buffer_load_dword v52, v7, s[8:11], s32 offen
    s_add_u32 s32, s47, 55296
    buffer_load_dword v53, v7, s[8:11], s32 offen
    s_add_u32 m0, s49, 0
    s_nop 0
    buffer_load_dwordx4 v4, s[4:7], s48 offen lds
    s_add_u32 m0, s49, 8192
    s_nop 0
    buffer_load_dwordx4 v5, s[4:7], s48 offen lds
    s_add_u32 s48, s48, 160
    s_min_u32 s48, s48, 1120
    s_add_u32 s49, s49, 20480
    s_min_u32 s49, s49, s30
    ds_read_b128 v[84:87], v17 offset:0
    ds_read_b128 v[88:91], v17 offset:5120
    ds_read_b128 v[92:95], v17 offset:10240
    ds_read_b128 v[96:99], v17 offset:15360
    s_waitcnt lgkmcnt(4)
    v_mfma_f32_32x32x16_bf16 v[120:135], v[104:107], v[64:67], v[120:135]
    v_bfe_u32 v34, v46, 24, 6
    v_bfe_u32 v35, v47, 0, 6
    v_lshl_or_b32 v34, v35, 16, v34
    v_lshl_or_b32 v35, v34, 5, v34
    v_and_b32 v36, 0x07070707, v35
    v_mfma_f32_32x32x16_bf16 v[136:151], v[104:107], v[68:71], v[136:151]
    v_perm_b32 v37, v27, v26, v36
    v_perm_b32 v38, v29, v28, v36
    v_perm_b32 v112, v38, v37, s28
    v_perm_b32 v113, v38, v37, s29
    v_bfe_u32 v34, v47, 6, 6
    v_mfma_f32_32x32x16_bf16 v[152:167], v[104:107], v[72:75], v[152:167]
    v_bfe_u32 v35, v47, 12, 6
    v_lshl_or_b32 v34, v35, 16, v34
    v_lshl_or_b32 v35, v34, 5, v34
    v_and_b32 v36, 0x07070707, v35
    v_perm_b32 v37, v27, v26, v36
    v_mfma_f32_32x32x16_bf16 v[168:183], v[104:107], v[76:79], v[168:183]
    v_perm_b32 v38, v29, v28, v36
    v_perm_b32 v114, v38, v37, s28
    v_perm_b32 v115, v38, v37, s29
    ds_read_b128 v[64:67], v18 offset:0
    ds_read_b128 v[68:71], v18 offset:5120
    ds_read_b128 v[72:75], v18 offset:10240
    ds_read_b128 v[76:79], v18 offset:15360
    s_waitcnt lgkmcnt(4)
    v_mfma_f32_32x32x16_bf16 v[120:135], v[112:115], v[84:87], v[120:135]
    v_bfe_u32 v34, v47, 18, 6
    v_bfe_u32 v35, v47, 24, 6
    v_lshl_or_b32 v34, v35, 16, v34
    v_lshl_or_b32 v35, v34, 5, v34
    v_and_b32 v36, 0x07070707, v35
    v_mfma_f32_32x32x16_bf16 v[136:151], v[112:115], v[88:91], v[136:151]
    v_perm_b32 v37, v27, v26, v36
    v_perm_b32 v38, v29, v28, v36
    v_perm_b32 v104, v38, v37, s28
    v_perm_b32 v105, v38, v37, s29
    v_bfe_u32 v34, v48, 0, 6
    v_mfma_f32_32x32x16_bf16 v[152:167], v[112:115], v[92:95], v[152:167]
    v_bfe_u32 v35, v48, 6, 6
    v_lshl_or_b32 v34, v35, 16, v34
    v_lshl_or_b32 v35, v34, 5, v34
    v_and_b32 v36, 0x07070707, v35
    v_perm_b32 v37, v27, v26, v36
    v_mfma_f32_32x32x16_bf16 v[168:183], v[112:115], v[96:99], v[168:183]
    v_perm_b32 v38, v29, v28, v36
    v_perm_b32 v106, v38, v37, s28
    v_perm_b32 v107, v38, v37, s29
    ds_read_b128 v[84:87], v19 offset:0
    ds_read_b128 v[88:91], v19 offset:5120
    ds_read_b128 v[92:95], v19 offset:10240
    ds_read_b128 v[96:99], v19 offset:15360
    s_waitcnt lgkmcnt(4)
    v_mfma_f32_32x32x16_bf16 v[120:135], v[104:107], v[64:67], v[120:135]
    v_bfe_u32 v34, v48, 12, 6
    v_bfe_u32 v35, v48, 18, 6
    v_lshl_or_b32 v34, v35, 16, v34
    v_lshl_or_b32 v35, v34, 5, v34
    v_and_b32 v36, 0x07070707, v35
    v_mfma_f32_32x32x16_bf16 v[136:151], v[104:107], v[68:71], v[136:151]
    v_perm_b32 v37, v27, v26, v36
    v_perm_b32 v38, v29, v28, v36
    v_perm_b32 v112, v38, v37, s28
    v_perm_b32 v113, v38, v37, s29
    v_bfe_u32 v34, v48, 24, 6
    v_mfma_f32_32x32x16_bf16 v[152:167], v[104:107], v[72:75], v[152:167]
    v_bfe_u32 v35, v49, 0, 6
    v_lshl_or_b32 v34, v35, 16, v34
    v_lshl_or_b32 v35, v34, 5, v34
    v_and_b32 v36, 0x07070707, v35
    v_perm_b32 v37, v27, v26, v36
    v_mfma_f32_32x32x16_bf16 v[168:183], v[104:107], v[76:79], v[168:183]
    v_perm_b32 v38, v29, v28, v36
    v_perm_b32 v114, v38, v37, s28
    v_perm_b32 v115, v38, v37, s29
    ds_read_b128 v[64:67], v20 offset:0
    ds_read_b128 v[68:71], v20 offset:5120
    ds_read_b128 v[72:75], v20 offset:10240
    ds_read_b128 v[76:79], v20 offset:15360
    s_waitcnt lgkmcnt(4)
    v_mfma_f32_32x32x16_bf16 v[120:135], v[112:115], v[84:87], v[120:135]
    v_bfe_u32 v34, v49, 6, 6
    v_bfe_u32 v35, v49, 12, 6
    v_lshl_or_b32 v34, v35, 16, v34
    v_lshl_or_b32 v35, v34, 5, v34
    v_and_b32 v36, 0x07070707, v35
    v_mfma_f32_32x32x16_bf16 v[136:151], v[112:115], v[88:91], v[136:151]
    v_perm_b32 v37, v27, v26, v36
    v_perm_b32 v38, v29, v28, v36
    v_perm_b32 v104, v38, v37, s28
    v_perm_b32 v105, v38, v37, s29
    v_bfe_u32 v34, v49, 18, 6
    v_mfma_f32_32x32x16_bf16 v[152:167], v[112:115], v[92:95], v[152:167]
    v_bfe_u32 v35, v49, 24, 6
    v_lshl_or_b32 v34, v35, 16, v34
    v_lshl_or_b32 v35, v34, 5, v34
    v_and_b32 v36, 0x07070707, v35
    v_perm_b32 v37, v27, v26, v36
    v_mfma_f32_32x32x16_bf16 v[168:183], v[112:115], v[96:99], v[168:183]
    v_perm_b32 v38, v29, v28, v36
    v_perm_b32 v106, v38, v37, s28
    v_perm_b32 v107, v38, v37, s29
    s_waitcnt vmcnt(2)
    s_barrier
    v_add_u32 v16, 20480, v16
    v_add_u32 v17, 20480, v17
    v_add_u32 v18, 20480, v18
    v_add_u32 v19, 20480, v19
    v_add_u32 v20, 20480, v20
    ds_read_b128 v[84:87], v16 offset:0
    ds_read_b128 v[88:91], v16 offset:5120
    ds_read_b128 v[92:95], v16 offset:10240
    ds_read_b128 v[96:99], v16 offset:15360
    s_waitcnt lgkmcnt(4)
    v_mfma_f32_32x32x16_bf16 v[120:135], v[104:107], v[64:67], v[120:135]
    v_bfe_u32 v34, v50, 0, 6
    v_bfe_u32 v35, v50, 6, 6
    v_lshl_or_b32 v34, v35, 16, v34
    v_lshl_or_b32 v35, v34, 5, v34
    v_and_b32 v36, 0x07070707, v35
    v_mfma_f32_32x32x16_bf16 v[136:151], v[104:107], v[68:71], v[136:151]
    v_perm_b32 v37, v27, v26, v36
    v_perm_b32 v38, v29, v28, v36
    v_perm_b32 v112, v38, v37, s28
    v_perm_b32 v113, v38, v37, s29
    v_bfe_u32 v34, v50, 12, 6
    v_mfma_f32_32x32x16_bf16 v[152:167], v[104:107], v[72:75], v[152:167]
    v_bfe_u32 v35, v50, 18, 6
    v_lshl_or_b32 v34, v35, 16, v34
    v_lshl_or_b32 v35, v34, 5, v34
    v_and_b32 v36, 0x07070707, v35
    v_perm_b32 v37, v27, v26, v36
    v_mfma_f32_32x32x16_bf16 v[168:183], v[104:107], v[76:79], v[168:183]
    v_perm_b32 v38, v29, v28, v36
    v_perm_b32 v114, v38, v37, s28
    v_perm_b32 v115, v38, v37, s29
    s_add_u32 s46, s46, 1
    s_cmp_eq_u32 s46, 7
    s_cbranch_scc1 L_doneB0
    s_add_u32 s47, s47, 147456
    s_add_u32 s32, s47, 0
    buffer_load_dword v46, v7, s[8:11], s32 offen
    s_add_u32 s32, s47, 18432
    buffer_load_dword v47, v7, s[8:11], s32 offen
    s_add_u32 s32, s47, 36864
    buffer_load_dword v48, v7, s[8:11], s32 offen
    s_add_u32 s32, s47, 55296
    buffer_load_dword v49, v7, s[8:11], s32 offen
    s_add_u32 m0, s49, 0
    s_nop 0
    buffer_load_dwordx4 v4, s[4:7], s48 offen lds
    s_add_u32 m0, s49, 8192
    s_nop 0
    buffer_load_dwordx4 v5, s[4:7], s48 offen lds
    s_add_u32 s48, s48, 160
    s_min_u32 s48, s48, 1120
    s_add_u32 s49, s49, 20480
    s_min_u32 s49, s49, s30
    ds_read_b128 v[64:67], v17 offset:0
    ds_read_b128 v[68:71], v17 offset:5120
    ds_read_b128 v[72:75], v17 offset:10240
    ds_read_b128 v[76:79], v17 offset:15360
    s_waitcnt lgkmcnt(4)
    v_mfma_f32_32x32x16_bf16 v[120:135], v[112:115], v[84:87], v[120:135]
    v_bfe_u32 v34, v50, 24, 6
    v_bfe_u32 v35, v51, 0, 6
    v_lshl_or_b32 v34, v35, 16, v34
    v_lshl_or_b32 v35, v34, 5, v34
    v_and_b32 v36, 0x07070707, v35
    v_mfma_f32_32x32x16_bf16 v[136:151], v[112:115], v[88:91], v[136:151]
    v_perm_b32 v37, v27, v26, v36
    v_perm_b32 v38, v29, v28, v36
    v_perm_b32 v104, v38, v37, s28
    v_perm_b32 v105, v38, v37, s29
    v_bfe_u32 v34, v51, 6, 6
    v_mfma_f32_32x32x16_bf16 v[152:167], v[112:115], v[92:95], v[152:167]
    v_bfe_u32 v35, v51, 12, 6
    v_lshl_or_b32 v34, v35, 16, v34
    v_lshl_or_b32 v35, v34, 5, v34
    v_and_b32 v36, 0x07070707, v35
    v_perm_b32 v37, v27, v26, v36
    v_mfma_f32_32x32x16_bf16 v[168:183], v[112:115], v[96:99], v[168:183]
    v_perm_b32 v38, v29, v28, v36
    v_perm_b32 v106, v38, v37, s28
    v_perm_b32 v107, v38, v37, s29
    ds_read_b128 v[84:87], v18 offset:0
    ds_read_b128 v[88:91], v18 offset:5120
    ds_read_b128 v[92:95], v18 offset:10240
    ds_read_b128 v[96:99], v18 offset:15360
    s_waitcnt lgkmcnt(4)
    v_mfma_f32_32x32x16_bf16 v[120:135], v[104:107], v[64:67], v[120:135]
    v_bfe_u32 v34, v51, 18, 6
    v_bfe_u32 v35, v51, 24, 6
    v_lshl_or_b32 v34, v35, 16, v34
    v_lshl_or_b32 v35, v34, 5, v34
    v_and_b32 v36, 0x07070707, v35
    v_mfma_f32_32x32x16_bf16 v[136:151], v[104:107], v[68:71], v[136:151]
    v_perm_b32 v37, v27, v26, v36
    v_perm_b32 v38, v29, v28, v36
    v_perm_b32 v112, v38, v37, s28
    v_perm_b32 v113, v38, v37, s29
    v_bfe_u32 v34, v52, 0, 6
    v_mfma_f32_32x32x16_bf16 v[152:167], v[104:107], v[72:75], v[152:167]
    v_bfe_u32 v35, v52, 6, 6
    v_lshl_or_b32 v34, v35, 16, v34
    v_lshl_or_b32 v35, v34, 5, v34
    v_and_b32 v36, 0x07070707, v35
    v_perm_b32 v37, v27, v26, v36
    v_mfma_f32_32x32x16_bf16 v[168:183], v[104:107], v[76:79], v[168:183]
    v_perm_b32 v38, v29, v28, v36
    v_perm_b32 v114, v38, v37, s28
    v_perm_b32 v115, v38, v37, s29
    ds_read_b128 v[64:67], v19 offset:0
    ds_read_b128 v[68:71], v19 offset:5120
    ds_read_b128 v[72:75], v19 offset:10240
    ds_read_b128 v[76:79], v19 offset:15360
    s_waitcnt lgkmcnt(4)
    v_mfma_f32_32x32x16_bf16 v[120:135], v[112:115], v[84:87], v[120:135]
    v_bfe_u32 v34, v52, 12, 6
    v_bfe_u32 v35, v52, 18, 6
    v_lshl_or_b32 v34, v35, 16, v34
    v_lshl_or_b32 v35, v34, 5, v34
    v_and_b32 v36, 0x07070707, v35
    v_mfma_f32_32x32x16_bf16 v[136:151], v[112:115], v[88:91], v[136:151]
    v_perm_b32 v37, v27, v26, v36
    v_perm_b32 v38, v29, v28, v36
    v_perm_b32 v104, v38, v37, s28
    v_perm_b32 v105, v38, v37, s29
    v_bfe_u32 v34, v52, 24, 6
    v_mfma_f32_32x32x16_bf16 v[152:167], v[112:115], v[92:95], v[152:167]
    v_bfe_u32 v35, v53, 0, 6
    v_lshl_or_b32 v34, v35, 16, v34
    v_lshl_or_b32 v35, v34, 5, v34
    v_and_b32 v36, 0x07070707, v35
    v_perm_b32 v37, v27, v26, v36
    v_mfma_f32_32x32x16_bf16 v[168:183], v[112:115], v[96:99], v[168:183]
    v_perm_b32 v38, v29, v28, v36
    v_perm_b32 v106, v38, v37, s28
    v_perm_b32 v107, v38, v37, s29
    ds_read_b128 v[84:87], v20 offset:0
    ds_read_b128 v[88:91], v20 offset:5120
    ds_read_b128 v[92:95], v20 offset:10240
    ds_read_b128 v[96:99], v20 offset:15360
    s_waitcnt lgkmcnt(4)
    v_mfma_f32_32x32x16_bf16 v[120:135], v[104:107], v[64:67], v[120:135]
    v_bfe_u32 v34, v53, 6, 6
    v_bfe_u32 v35, v53, 12, 6
    v_lshl_or_b32 v34, v35, 16, v34
    v_lshl_or_b32 v35, v34, 5, v34
    v_and_b32 v36, 0x07070707, v35
    v_mfma_f32_32x32x16_bf16 v[136:151], v[104:107], v[68:71], v[136:151]
    v_perm_b32 v37, v27, v26, v36
    v_perm_b32 v38, v29, v28, v36
    v_perm_b32 v112, v38, v37, s28
    v_perm_b32 v113, v38, v37, s29
    v_bfe_u32 v34, v53, 18, 6
    v_mfma_f32_32x32x16_bf16 v[152:167], v[104:107], v[72:75], v[152:167]
    v_bfe_u32 v35, v53, 24, 6
    v_lshl_or_b32 v34, v35, 16, v34
    v_lshl_or_b32 v35, v34, 5, v34
    v_and_b32 v36, 0x07070707, v35
    v_perm_b32 v37, v27, v26, v36
    v_mfma_f32_32x32x16_bf16 v[168:183], v[104:107], v[76:79], v[168:183]
    v_perm_b32 v38, v29, v28, v36
    v_perm_b32 v114, v38, v37, s28
    v_perm_b32 v115, v38, v37, s29
    s_waitcnt vmcnt(2)
    s_barrier
    v_add_u32 v16, 20480, v16
    v_add_u32 v17, 20480, v17
    v_add_u32 v18, 20480, v18
    v_add_u32 v19, 20480, v19
    v_add_u32 v20, 20480, v20
    ds_read_b128 v[64:67], v16 offset:0
    ds_read_b128 v[68:71], v16 offset:5120
    ds_read_b128 v[72:75], v16 offset:10240
    ds_read_b128 v[76:79], v16 offset:15360
    s_waitcnt lgkmcnt(4)
    v_mfma_f32_32x32x16_bf16 v[120:135], v[112:115], v[84:87], v[120:135]
    v_bfe_u32 v34, v46, 0, 6
    v_bfe_u32 v35, v46, 6, 6
    v_lshl_or_b32 v34, v35, 16, v34
    v_lshl_or_b32 v35, v34, 5, v34
    v_and_b32 v36, 0x07070707, v35
    v_mfma_f32_32x32x16_bf16 v[136:151], v[112:115], v[88:91], v[136:151]
    v_perm_b32 v37, v27, v26, v36
    v_perm_b32 v38, v29, v28, v36
    v_perm_b32 v104, v38, v37, s28
    v_perm_b32 v105, v38, v37, s29
    v_bfe_u32 v34, v46, 12, 6
    v_mfma_f32_32x32x16_bf16 v[152:167], v[112:115], v[92:95], v[152:167]
    v_bfe_u32 v35, v46, 18, 6
    v_lshl_or_b32 v34, v35, 16, v34
    v_lshl_or_b32 v35, v34, 5, v34
    v_and_b32 v36, 0x07070707, v35
    v_perm_b32 v37, v27, v26, v36
    v_mfma_f32_32x32x16_bf16 v[168:183], v[112:115], v[96:99], v[168:183]
    v_perm_b32 v38, v29, v28, v36
    v_perm_b32 v106, v38, v37, s28
    v_perm_b32 v107, v38, v37, s29
    s_add_u32 s46, s46, 1
    s_cmp_eq_u32 s46, 7
    s_cbranch_scc1 L_doneB1
    s_branch L_loopB
L_doneB1:
    s_endpgm
L_doneB0:
    s_waitcnt lgkmcnt(0)
    ds_read_b128 v[84:87], v14 offset:0
    ds_read_b128 v[88:91], v14 offset:5120
    ds_read_b128 v[92:95], v14 offset:10240
    ds_read_b128 v[96:99], v14 offset:15360
    v_lshrrev_b32 v39, v12, v54
    v_bfe_u32 v34, v39, 0, 6
    v_bfe_u32 v35, v39, 6, 6
    v_lshl_or_b32 v34, v35, 16, v34
    v_lshl_or_b32 v35, v34, 5, v34
    v_and_b32 v36, 0x07070707, v35
    v_perm_b32 v37, v27, v26, v36
    v_perm_b32 v38, v29, v28, v36
    v_perm_b32 v112, v38, v37, s28
    v_perm_b32 v113, v38, v37, s29
    v_bfe_u32 v34, v39, 12, 6
    v_bfe_u32 v35, v39, 18, 6
    v_lshl_or_b32 v34, v35, 16, v34
    v_lshl_or_b32 v35, v34, 5, v34
    v_and_b32 v36, 0x07070707, v35
    v_perm_b32 v37, v27, v26, v36
    v_perm_b32 v38, v29, v28, v36
    v_perm_b32 v114, v38, v37, s28
    v_perm_b32 v115, v38, v37, s29
    v_and_b32 v113, v13, v113
    v_and_b32 v114, v13, v114
    v_and_b32 v115, v13, v115
    s_waitcnt lgkmcnt(0)
    s_nop 1
    v_mfma_f32_32x32x16_bf16 v[120:135], v[112:115], v[84:87], v[120:135]
    v_mfma_f32_32x32x16_bf16 v[136:151], v[112:115], v[88:91], v[136:151]
    v_mfma_f32_32x32x16_bf16 v[152:167], v[112:115], v[92:95], v[152:167]
    v_mfma_f32_32x32x16_bf16 v[168:183], v[112:115], v[96:99], v[168:183]
    s_nop 15
    s_nop 7
    v_cvt_pk_bf16_f32 v64, v120, v121
    v_cvt_pk_bf16_f32 v65, v122, v123
    v_cvt_pk_bf16_f32 v66, v124, v125
    v_cvt_pk_bf16_f32 v67, v126, v127
    v_cvt_pk_bf16_f32 v68, v128, v129
    v_cvt_pk_bf16_f32 v69, v130, v131
    v_cvt_pk_bf16_f32 v70, v132, v133
    v_cvt_pk_bf16_f32 v71, v134, v135
    v_permlane32_swap_b32 v64, v66
    v_permlane32_swap_b32 v65, v67
    v_permlane32_swap_b32 v68, v70
    v_permlane32_swap_b32 v69, v71
    s_mov_b32 s32, 0
    buffer_store_dwordx4 v[64:67], v11, s[20:23], s32 offen offset:0
    buffer_store_dwordx4 v[68:71], v11, s[20:23], s32 offen offset:32
    v_cvt_pk_bf16_f32 v72, v136, v137
    v_cvt_pk_bf16_f32 v73, v138, v139
    v_cvt_pk_bf16_f32 v74, v140, v141
    v_cvt_pk_bf16_f32 v75, v142, v143
    v_cvt_pk_bf16_f32 v76, v144, v145
    v_cvt_pk_bf16_f32 v77, v146, v147
    v_cvt_pk_bf16_f32 v78, v148, v149
    v_cvt_pk_bf16_f32 v79, v150, v151
    v_permlane32_swap_b32 v72, v74
    v_permlane32_swap_b32 v73, v75
    v_permlane32_swap_b32 v76, v78
    v_permlane32_swap_b32 v77, v79
    s_mov_b32 s32, 294912
    buffer_store_dwordx4 v[72:75], v11, s[20:23], s32 offen offset:0
    buffer_store_dwordx4 v[76:79], v11, s[20:23], s32 offen offset:32
    v_cvt_pk_bf16_f32 v84, v152, v153
    v_cvt_pk_bf16_f32 v85, v154, v155
    v_cvt_pk_bf16_f32 v86, v156, v157
    v_cvt_pk_bf16_f32 v87, v158, v159
    v_cvt_pk_bf16_f32 v88, v160, v161
    v_cvt_pk_bf16_f32 v89, v162, v163
    v_cvt_pk_bf16_f32 v90, v164, v165
    v_cvt_pk_bf16_f32 v91, v166, v167
    v_permlane32_swap_b32 v84, v86
    v_permlane32_swap_b32 v85, v87
    v_permlane32_swap_b32 v88, v90
    v_permlane32_swap_b32 v89, v91
    s_mov_b32 s32, 589824
    buffer_store_dwordx4 v[84:87], v11, s[20:23], s32 offen offset:0
    buffer_store_dwordx4 v[88:91], v11, s[20:23], s32 offen offset:32
    v_cvt_pk_bf16_f32 v92, v168, v169
    v_cvt_pk_bf16_f32 v93, v170, v171
    v_cvt_pk_bf16_f32 v94, v172, v173
    v_cvt_pk_bf16_f32 v95, v174, v175
    v_cvt_pk_bf16_f32 v96, v176, v177
    v_cvt_pk_bf16_f32 v97, v178, v179
    v_cvt_pk_bf16_f32 v98, v180, v181
    v_cvt_pk_bf16_f32 v99, v182, v183
    v_permlane32_swap_b32 v92, v94
    v_permlane32_swap_b32 v93, v95
    v_permlane32_swap_b32 v96, v98
    v_permlane32_swap_b32 v97, v99
    s_mov_b32 s32, 884736
    buffer_store_dwordx4 v[92:95], v11, s[20:23], s32 offen offset:0
    buffer_store_dwordx4 v[96:99], v11, s[20:23], s32 offen offset:32
    s_endpgm
L_exit:
    s_endpgm
.section .rodata,"a"
.p2align 6
.amdhsa_kernel standalone__weight_only_int_gptq__prompt_kernel
  .amdhsa_next_free_vgpr 200
  .amdhsa_next_free_sgpr 64
  .amdhsa_accum_offset 200
  .amdhsa_group_segment_fixed_size 0
  .amdhsa_kernarg_size 64
  .amdhsa_user_sgpr_count 2
  .amdhsa_user_sgpr_kernarg_segment_ptr 1
  .amdhsa_system_sgpr_workgroup_id_x 1
  .amdhsa_float_denorm_mode_32 3
.end_amdhsa_kernel
```
